```python
import torch

def _softmax(x, axis=-1):
    return torch.softmax(x, dim=axis)
def _gelu(x):
    return torch.nn.functional.gelu(x, approximate="tanh")
def _silu(x):
    return torch.nn.functional.silu(x)
def _sigmoid(x):
    return torch.sigmoid(x)
def _layernorm(x, axis=-1, eps=1e-5):
    m = x.mean(dim=axis, keepdim=True)
    v = x.var(dim=axis, keepdim=True, unbiased=False)
    return (x - m) / torch.sqrt(v + eps)
def _scatter_add(tgt, idx, src, axis=0):
    return tgt.clone().index_add_(axis, idx, src)
def _segment_sum(src, seg, n):
    out = torch.zeros((n,) + src.shape[1:], dtype=src.dtype)
    return out.index_add_(0, seg, src)
def _pad(x, pw):
    flat = tuple(v for pair in reversed(pw) for v in pair)
    return torch.nn.functional.pad(x, flat)

kernel_name = 'standalone__glu_gated_bilinear__decode'

def setup_inputs():

    _w = (lambda a: (lambda t: t.to(torch.bfloat16) if t.is_floating_point() else t)(torch.as_tensor(a)))
    B, S, D, F = 1, 1, 1024, 3584
    return {
        "x": _w((lambda *s: torch.randn(*s, dtype=torch.bfloat16) * 0.05)(B, S, D)),
        "w_gate": _w((lambda *s: torch.randn(*s, dtype=torch.bfloat16) * 0.05)(D, F) * (D ** -0.5)),
        "w_up": _w((lambda *s: torch.randn(*s, dtype=torch.bfloat16) * 0.05)(D, F) * (D ** -0.5)),
        "w_down": _w((lambda *s: torch.randn(*s, dtype=torch.bfloat16) * 0.05)(F, D) * (F ** -0.5)),
    }

def reference(x, w_gate, w_up, w_down):
    g = torch.einsum("bsd,df->bsf", x, w_gate)
    u = torch.einsum("bsd,df->bsf", x, w_up)
    h = g * u
    return torch.einsum("bsf,fd->bsd", h, w_down)
```

```asm
; @launch grid=(256,1,1) block=(512,1,1) lds=4352
.amdgcn_target "amdgcn-amd-amdhsa--gfx950"
.text
.globl standalone__glu_gated_bilinear__decode_kernel
.p2align 8
.type standalone__glu_gated_bilinear__decode_kernel,@function
standalone__glu_gated_bilinear__decode_kernel:
  s_load_dwordx8 s[4:11], s[0:1], 0
  s_load_dwordx4 s[12:15], s[0:1], 32
  s_load_dwordx2 s[16:17], s[0:1], 48
  s_cmp_ge_u32 s2, 256
  s_cbranch_scc1 L_end
  v_lshrrev_b32 v1, 6, v0
  s_and_b32 s18, s2, 7
  v_readfirstlane_b32 s20, v1
  s_lshr_b32 s19, s2, 3
  s_sub_u32 s19, s19, 4
  s_and_b32 s19, s19, 31
  v_and_b32 v2, 15, v0
  v_bfe_u32 v3, v0, 4, 2
  s_cmp_lt_u32 s19, 28
  s_cbranch_scc1 L_stream
  s_lshl_b32 s21, s18, 2
  s_add_u32 s21, s21, s19
  s_sub_u32 s21, s21, 28
  v_and_b32 v4, 63, v0
  v_lshlrev_b32 v4, 4, v4
  v_mov_b32 v16, -1
  v_mov_b32 v17, -1
  v_mov_b32 v18, -1
  v_mov_b32 v19, -1
  s_cmp_eq_u32 s20, 7
  s_cbranch_scc1 L_svc7
  s_mul_i32 s22, s21, 7
  s_add_u32 s22, s22, s20
  s_lshl_b32 s23, s22, 10
  v_add_u32 v5, s23, v4
  v_add_u32 v9, 1048576, v5
  s_waitcnt lgkmcnt(0)
  s_mov_b32 exec_lo, 0xf
  s_mov_b32 exec_hi, 0
  global_store_dwordx4 v9, v[16:19], s[16:17] sc0 sc1
  s_mov_b64 exec, -1
  global_store_dwordx4 v5, v[16:19], s[16:17]
  s_branch L_svc
L_svc7:
  s_lshl_b32 s22, s21, 12
  s_add_u32 s22, s22, 524288
  v_add_u32 v5, s22, v4
  v_cmp_gt_u32 vcc, 512, v4
  s_nop 1
  v_cndmask_b32 v20, 0, v16, vcc
  v_mov_b32 v21, v20
  v_mov_b32 v22, v20
  v_mov_b32 v23, v20
  s_waitcnt lgkmcnt(0)
  global_store_dwordx4 v5, v[16:19], s[16:17] offset:0
  global_store_dwordx4 v5, v[16:19], s[16:17] offset:1024
  global_store_dwordx4 v5, v[16:19], s[16:17] offset:2048
  global_store_dwordx4 v5, v[20:23], s[16:17] offset:3072
  s_branch L_svc7b
L_stream:
  s_lshl_b32 s21, s19, 3
  s_add_u32 s21, s21, s20
  s_lshl_b32 s24, s19, 2
  s_and_b32 s23, s20, 3
  s_add_u32 s24, s24, s23
  s_mul_i32 s22, s24, 4682
  s_lshr_b32 s22, s22, 16
  s_mul_i32 s23, s22, 14
  s_sub_u32 s23, s24, s23
  s_cmp_ge_u32 s23, 7
  s_cselect_b32 s24, 7, 0
  s_cselect_b32 s25, 1, 0
  s_sub_u32 s23, s23, s24
  s_mul_i32 s26, s18, 7
  s_add_u32 s26, s26, s23
  s_lshl_b32 s27, s26, 7
  s_lshl_b32 s29, s22, 1
  s_lshr_b32 s28, s20, 2
  s_add_u32 s29, s29, s28
  s_mul_i32 s28, s29, 458752
  s_add_u32 s27, s27, s28
  v_lshrrev_b32 v4, 3, v2
  v_lshl_add_u32 v4, v4, 2, v3
  v_and_b32 v5, 7, v2
  v_mul_u32_u24 v6, 57344, v4
  v_lshl_add_u32 v6, v5, 4, v6
  v_lshlrev_b32 v7, 4, v4
  s_lshl_b32 s29, s29, 7
  v_add_u32 v7, s29, v7
  s_mov_b32 s34, 7340032
  s_mov_b32 s35, 0x20000
  s_cmp_eq_u32 s25, 1
  s_waitcnt lgkmcnt(0)
  s_cselect_b32 s32, s8, s6
  s_cselect_b32 s33, s9, s7
  global_load_dwordx4 v[12:15], v7, s[4:5]
  buffer_load_dwordx4 v[16:19], v6, s[32:35], s27 offen nt
  s_add_u32 s27, s27, 7168
  buffer_load_dwordx4 v[20:23], v6, s[32:35], s27 offen nt
  s_add_u32 s27, s27, 7168
  buffer_load_dwordx4 v[24:27], v6, s[32:35], s27 offen nt
  s_add_u32 s27, s27, 7168
  buffer_load_dwordx4 v[28:31], v6, s[32:35], s27 offen nt
  s_add_u32 s27, s27, 7168
  buffer_load_dwordx4 v[32:35], v6, s[32:35], s27 offen nt
  s_add_u32 s27, s27, 7168
  buffer_load_dwordx4 v[36:39], v6, s[32:35], s27 offen nt
  s_add_u32 s27, s27, 7168
  buffer_load_dwordx4 v[40:43], v6, s[32:35], s27 offen nt
  s_add_u32 s27, s27, 7168
  buffer_load_dwordx4 v[44:47], v6, s[32:35], s27 offen nt
  s_getreg_b32 s3, hwreg(HW_REG_XCC_ID, 0, 4)
  v_and_b32 v9, 1, v5
  v_cmp_eq_u32 vcc, 1, v9
  v_mov_b32 v9, 0x0c0c0100
  v_mov_b32 v10, 0x01000c0c
  v_cndmask_b32 v9, v9, v10, vcc
  v_mov_b32 v10, 0x0c0c0302
  v_mov_b32 v11, 0x03020c0c
  v_cndmask_b32 v10, v10, v11, vcc
  v_lshrrev_b32 v11, 1, v5
  v_mov_b32 v111, 0x0c0c0c0c
  v_cmp_eq_u32 s[42:43], 0, v11
  v_cmp_eq_u32 s[44:45], 1, v11
  v_cmp_eq_u32 s[46:47], 2, v11
  v_cmp_eq_u32 s[48:49], 3, v11
  s_nop 1
  v_cndmask_b32 v96, v111, v9, s[42:43]
  v_cndmask_b32 v97, v111, v10, s[42:43]
  v_cndmask_b32 v98, v111, v9, s[44:45]
  v_cndmask_b32 v99, v111, v10, s[44:45]
  v_cndmask_b32 v100, v111, v9, s[46:47]
  v_cndmask_b32 v101, v111, v10, s[46:47]
  v_cndmask_b32 v102, v111, v9, s[48:49]
  v_cndmask_b32 v103, v111, v10, s[48:49]
  v_lshl_add_u32 v9, v2, 1, v3
  v_lshrrev_b32 v104, 2, v9
  v_lshlrev_b32 v104, 10, v104
  v_and_b32 v10, 3, v9
  v_lshl_add_u32 v104, v10, 4, v104
  s_lshl_b32 s41, s26, 12
  s_lshl_b32 s42, s25, 9
  s_add_u32 s41, s41, s42
  s_lshl_b32 s42, s22, 6
  s_add_u32 s41, s41, s42
  v_and_b32 v11, 0xff, v0
  v_lshlrev_b32 v11, 4, v11
  v_add_u32 v104, s41, v104
  s_lshl_b32 s40, s18, 2
  s_or_b32 s3, s3, 0x10
  s_mul_i32 s3, s3, 0x01010101
  s_lshl_b32 s42, s20, 9
  v_lshlrev_b32 v105, 4, v9
  v_add_u32 v105, s42, v105
  v_and_b32 v9, 31, v0
  v_lshlrev_b32 v106, 4, v9
  v_bfe_u32 v10, v0, 5, 1
  v_lshl_add_u32 v106, v10, 11, v106
  v_lshrrev_b32 v108, 3, v9
  v_lshlrev_b32 v107, 12, v108
  v_and_b32 v10, 7, v9
  v_lshl_add_u32 v107, v10, 4, v107
  s_lshl_b32 s42, s18, 14
  s_lshl_b32 s43, s19, 7
  s_add_u32 s42, s42, s43
  s_add_u32 s42, s42, 524288
  v_add_u32 v107, s42, v107
  s_lshl_b32 s43, s21, 3
  s_and_b32 s42, s18, 0
  s_add_u32 s43, s43, s42
  s_lshl_b32 s43, s43, 7
  s_add_u32 s43, s43, 1048576
  s_mul_i32 s73, s21, 9363
  s_lshr_b32 s73, s73, 16
  s_lshl_b32 s73, s73, 3
  s_lshl_b32 s30, s21, 15
  s_lshl_b32 s31, s18, 8
  s_add_u32 s30, s30, s31
  s_add_u32 s31, s30, 4096
  v_lshlrev_b32 v8, 13, v3
  v_lshl_add_u32 v8, v2, 4, v8
  s_mov_b32 s36, s10
  s_mov_b32 s37, s11
  s_mov_b32 s38, 7340032
  s_mov_b32 s39, 0x20000
  v_mov_b32 v109, 4096
  s_waitcnt vmcnt(8)
  v_perm_b32 v64, v12, v12, v96
  v_perm_b32 v65, v12, v12, v98
  v_perm_b32 v66, v12, v12, v100
  v_perm_b32 v67, v12, v12, v102
  v_perm_b32 v68, v12, v12, v97
  v_perm_b32 v69, v12, v12, v99
  v_perm_b32 v70, v12, v12, v101
  v_perm_b32 v71, v12, v12, v103
  v_perm_b32 v72, v13, v13, v96
  v_perm_b32 v73, v13, v13, v98
  v_perm_b32 v74, v13, v13, v100
  v_perm_b32 v75, v13, v13, v102
  v_perm_b32 v76, v13, v13, v97
  v_perm_b32 v77, v13, v13, v99
  v_perm_b32 v78, v13, v13, v101
  v_perm_b32 v79, v13, v13, v103
  v_perm_b32 v80, v14, v14, v96
  v_perm_b32 v81, v14, v14, v98
  v_perm_b32 v82, v14, v14, v100
  v_perm_b32 v83, v14, v14, v102
  v_perm_b32 v84, v14, v14, v97
  v_perm_b32 v85, v14, v14, v99
  v_perm_b32 v86, v14, v14, v101
  v_perm_b32 v87, v14, v14, v103
  v_perm_b32 v88, v15, v15, v96
  v_perm_b32 v89, v15, v15, v98
  v_perm_b32 v90, v15, v15, v100
  v_perm_b32 v91, v15, v15, v102
  v_perm_b32 v92, v15, v15, v97
  v_perm_b32 v93, v15, v15, v99
  v_perm_b32 v94, v15, v15, v101
  v_perm_b32 v95, v15, v15, v103
  s_cmp_eq_u32 s20, 0
  s_cbranch_scc1 L_ready
L_modeset:
  s_waitcnt vmcnt(7)
  v_mfma_f32_16x16x32_bf16 v[112:115], v[64:67], v[16:19], 0
  s_waitcnt vmcnt(6)
  v_mfma_f32_16x16x32_bf16 v[112:115], v[68:71], v[20:23], v[112:115]
  s_waitcnt vmcnt(5)
  v_mfma_f32_16x16x32_bf16 v[112:115], v[72:75], v[24:27], v[112:115]
  s_waitcnt vmcnt(4)
  v_mfma_f32_16x16x32_bf16 v[112:115], v[76:79], v[28:31], v[112:115]
  s_waitcnt vmcnt(3)
  v_mfma_f32_16x16x32_bf16 v[112:115], v[80:83], v[32:35], v[112:115]
  s_waitcnt vmcnt(2)
  v_mfma_f32_16x16x32_bf16 v[112:115], v[84:87], v[36:39], v[112:115]
  s_cmp_ge_u32 s20, 4
  s_cbranch_scc1 L_young
  s_waitcnt vmcnt(1)
  v_mfma_f32_16x16x32_bf16 v[112:115], v[88:91], v[40:43], v[112:115]
  s_waitcnt vmcnt(0)
  v_mfma_f32_16x16x32_bf16 v[112:115], v[92:95], v[44:47], v[112:115]
  s_nop 7
  ds_write_b128 v11, v[112:115]
  s_waitcnt lgkmcnt(0)
  s_barrier
  s_branch L_pubdone
L_young:
  s_barrier
  ds_read_b128 v[116:119], v11
  ds_read_b32 v110, v109
  s_nop 3
  s_waitcnt lgkmcnt(0)
  v_readfirstlane_b32 s47, v110
  v_pk_add_f32 v[112:113], v[112:113], v[116:117]
  v_pk_add_f32 v[114:115], v[114:115], v[118:119]
  s_nop 0
  s_waitcnt vmcnt(1)
  v_mfma_f32_16x16x32_bf16 v[112:115], v[88:91], v[40:43], v[112:115]
  s_waitcnt vmcnt(0)
  v_mfma_f32_16x16x32_bf16 v[112:115], v[92:95], v[44:47], v[112:115]
  s_nop 7
L_flagok:
  v_permlane32_swap_b32 v112, v116
  v_permlane32_swap_b32 v113, v117
  v_permlane32_swap_b32 v114, v118
  v_permlane32_swap_b32 v115, v119
  s_nop 1
  v_add_f32_dpp v112, v116, v112 row_ror:8 row_mask:0xf bank_mask:0xf
  v_add_f32_dpp v113, v117, v113 row_ror:8 row_mask:0xf bank_mask:0xf
  v_add_f32_dpp v114, v118, v114 row_ror:8 row_mask:0xf bank_mask:0xf
  v_add_f32_dpp v115, v119, v115 row_ror:8 row_mask:0xf bank_mask:0xf
  v_min_u32 v112, -2, v112
  v_min_u32 v113, -2, v113
  v_min_u32 v114, -2, v114
  v_min_u32 v115, -2, v115
  s_mov_b32 exec_lo, 0x00ff00ff
  s_mov_b32 exec_hi, 0
  s_cmp_lg_u32 s47, 1
  s_cbranch_scc1 L_slowpub
  global_store_dwordx4 v104, v[112:115], s[16:17]
L_pubdone:
  s_mov_b64 exec, -1
  s_load_dword s70, s[14:15], s73
  s_barrier
  buffer_load_dwordx4 v[48:51], v8, s[36:39], s30 offen offset:0 nt
  buffer_load_dwordx4 v[52:55], v8, s[36:39], s30 offen offset:2048 nt
L_armed:
  s_waitcnt vmcnt(1)
  buffer_load_dwordx4 v[56:59], v8, s[36:39], s31 offen offset:0 nt
  s_waitcnt vmcnt(1)
  buffer_load_dwordx4 v[60:63], v8, s[36:39], s31 offen offset:2048 nt
  s_mov_b32 s46, 0
  s_waitcnt lgkmcnt(0)
  s_bitcmp1_b32 s70, 4
  s_cbranch_scc0 L_hslow
L_h:
  s_load_dwordx16 s[48:63], s[16:17], s43 glc
  s_add_u32 s46, s46, 1
  s_waitcnt lgkmcnt(0)
  s_max_u32 s64, s48, s49
  s_max_u32 s65, s50, s51
  s_max_u32 s64, s64, s52
  s_max_u32 s65, s65, s53
  s_max_u32 s64, s64, s54
  s_max_u32 s65, s65, s55
  s_max_u32 s64, s64, s56
  s_max_u32 s65, s65, s57
  s_max_u32 s64, s64, s58
  s_max_u32 s65, s65, s59
  s_max_u32 s64, s64, s60
  s_max_u32 s65, s65, s61
  s_max_u32 s64, s64, s62
  s_max_u32 s65, s65, s63
  s_max_u32 s64, s64, s65
  s_cmp_eq_u32 s64, -1
  s_cbranch_scc0 L_hok
  s_cmp_lt_u32 s46, 8388608
  s_cbranch_scc1 L_h
L_hok:
  s_mov_b32 exec_lo, 0xffff
  s_mov_b32 exec_hi, 0x0
  v_mov_b32 v16, s48
  v_mov_b32 v17, s49
  v_mov_b32 v18, s50
  v_mov_b32 v19, s51
  s_mov_b32 exec_lo, 0xffff0000
  s_mov_b32 exec_hi, 0x0
  v_mov_b32 v16, s52
  v_mov_b32 v17, s53
  v_mov_b32 v18, s54
  v_mov_b32 v19, s55
  s_mov_b32 exec_lo, 0x0
  s_mov_b32 exec_hi, 0xffff
  v_mov_b32 v16, s56
  v_mov_b32 v17, s57
  v_mov_b32 v18, s58
  v_mov_b32 v19, s59
  s_mov_b32 exec_lo, 0x0
  s_mov_b32 exec_hi, 0xffff0000
  v_mov_b32 v16, s60
  v_mov_b32 v17, s61
  v_mov_b32 v18, s62
  v_mov_b32 v19, s63
  s_mov_b64 exec, -1
  v_perm_b32 v64, v16, v16, v96
  v_perm_b32 v65, v16, v16, v98
  v_perm_b32 v66, v16, v16, v100
  v_perm_b32 v67, v16, v16, v102
  v_perm_b32 v68, v17, v17, v96
  v_perm_b32 v69, v17, v17, v98
  v_perm_b32 v70, v17, v17, v100
  v_perm_b32 v71, v17, v17, v102
  v_perm_b32 v72, v18, v18, v96
  v_perm_b32 v73, v18, v18, v98
  v_perm_b32 v74, v18, v18, v100
  v_perm_b32 v75, v18, v18, v102
  v_perm_b32 v76, v19, v19, v96
  v_perm_b32 v77, v19, v19, v98
  v_perm_b32 v78, v19, v19, v100
  v_perm_b32 v79, v19, v19, v102
  s_waitcnt vmcnt(3)
  v_mfma_f32_16x16x32_bf16 v[20:23], v[64:67], v[48:51], 0
  s_waitcnt vmcnt(2)
  v_mfma_f32_16x16x32_bf16 v[20:23], v[68:71], v[52:55], v[20:23]
  s_waitcnt vmcnt(1)
  v_mfma_f32_16x16x32_bf16 v[20:23], v[72:75], v[56:59], v[20:23]
  s_waitcnt vmcnt(0)
  v_mfma_f32_16x16x32_bf16 v[20:23], v[76:79], v[60:63], v[20:23]
  s_mov_b32 exec_hi, 0
  s_nop 6
  ds_write_b128 v105, v[20:23]
  s_mov_b64 exec, -1
  s_waitcnt lgkmcnt(0)
  s_barrier
  s_cmp_lg_u32 s20, 0
  s_cbranch_scc1 L_pdone
  ds_read_b128 v[24:27], v106 offset:0
  ds_read_b128 v[28:31], v106 offset:512
  ds_read_b128 v[32:35], v106 offset:1024
  ds_read_b128 v[36:39], v106 offset:1536
  s_waitcnt lgkmcnt(2)
  v_pk_add_f32 v[24:25], v[24:25], v[28:29]
  v_pk_add_f32 v[26:27], v[26:27], v[30:31]
  s_waitcnt lgkmcnt(0)
  v_pk_add_f32 v[32:33], v[32:33], v[36:37]
  v_pk_add_f32 v[34:35], v[34:35], v[38:39]
  v_pk_add_f32 v[112:113], v[24:25], v[32:33]
  v_pk_add_f32 v[114:115], v[26:27], v[34:35]
  s_nop 1
  v_permlane32_swap_b32 v112, v28
  v_permlane32_swap_b32 v113, v29
  v_permlane32_swap_b32 v114, v30
  v_permlane32_swap_b32 v115, v31
  v_pk_add_f32 v[112:113], v[112:113], v[28:29]
  v_pk_add_f32 v[114:115], v[114:115], v[30:31]
  v_min_u32 v112, -2, v112
  v_min_u32 v113, -2, v113
  v_min_u32 v114, -2, v114
  v_min_u32 v115, -2, v115
  s_mov_b32 exec_hi, 0
  s_cmp_lg_u32 s47, 1
  s_cbranch_scc1 L_slowpub2
  global_store_dwordx4 v107, v[112:115], s[16:17]
L_pub2done:
L_pdone:
L_end:
  s_endpgm
L_ready:
  s_waitcnt vmcnt(0)
L_ready1:
  s_lshl_b32 s28, s18, 5
  s_load_dwordx8 s[48:55], s[14:15], s28
  s_and_b32 s29, s3, 0xff
  s_waitcnt lgkmcnt(0)
  s_xor_b32 s48, s48, s29
  s_xor_b32 s50, s50, s29
  s_xor_b32 s52, s52, s29
  s_xor_b32 s54, s54, s29
  s_or_b32 s48, s48, s50
  s_or_b32 s52, s52, s54
  s_or_b32 s48, s48, s52
  s_mov_b32 s47, 1
  s_and_b32 s48, s48, 0xff
  s_cbranch_scc1 L_flagslow
L_setmode:
  v_mov_b32 v110, s47
  ds_write_b32 v109, v110
  s_waitcnt lgkmcnt(0)
  s_branch L_modeset
L_svc:
  v_mov_b32 v44, 0
  v_mov_b32 v45, 1
  s_waitcnt vmcnt(0)
  s_barrier
  s_barrier
  s_mov_b32 s46, 0
L_p1:
  global_load_dwordx4 v[16:19], v5, s[16:17] sc1
  s_add_u32 s46, s46, 1
  s_cmp_ge_u32 s46, 96
  s_cbranch_scc1 L_p1B
L_p1w:
  s_waitcnt vmcnt(0)
  v_max3_u32 v24, v16, v17, v18
  v_max_u32 v24, v24, v19
  v_cmp_eq_u32 vcc, -1, v24
  s_cbranch_vccnz L_p1
L_p1ok:
  v_add_f32_dpp v28, v16, v16 row_ror:8 row_mask:0xf bank_mask:0xf
  v_add_f32_dpp v29, v17, v17 row_ror:8 row_mask:0xf bank_mask:0xf
  v_add_f32_dpp v30, v18, v18 row_ror:8 row_mask:0xf bank_mask:0xf
  v_add_f32_dpp v31, v19, v19 row_ror:8 row_mask:0xf bank_mask:0xf
  v_add_f32_dpp v24, v28, v28 row_ror:4 row_mask:0xf bank_mask:0xf
  v_add_f32_dpp v25, v29, v29 row_ror:4 row_mask:0xf bank_mask:0xf
  v_add_f32_dpp v26, v30, v30 row_ror:4 row_mask:0xf bank_mask:0xf
  v_add_f32_dpp v27, v31, v31 row_ror:4 row_mask:0xf bank_mask:0xf
  v_mov_b32 v28, v24
  v_mov_b32 v29, v25
  v_mov_b32 v30, v26
  v_mov_b32 v31, v27
  v_permlane16_swap_b32 v24, v28
  v_permlane16_swap_b32 v25, v29
  v_permlane16_swap_b32 v26, v30
  v_permlane16_swap_b32 v27, v31
  v_pk_add_f32 v[28:29], v[24:25], v[28:29]
  v_pk_add_f32 v[30:31], v[26:27], v[30:31]
  v_cvt_pk_bf16_f32 v16, v28, v29
  v_cvt_pk_bf16_f32 v17, v30, v31
  v_mov_b32 v18, v16
  v_mov_b32 v19, v17
  s_nop 1
  v_permlane32_swap_b32 v16, v18
  v_permlane32_swap_b32 v17, v19
  v_lshlrev_b32 v24, 16, v16
  v_and_b32 v25, 0xffff0000, v16
  v_lshlrev_b32 v26, 16, v17
  v_and_b32 v27, 0xffff0000, v17
  v_lshlrev_b32 v28, 16, v18
  v_and_b32 v29, 0xffff0000, v18
  v_lshlrev_b32 v30, 16, v19
  v_and_b32 v31, 0xffff0000, v19
  v_pk_mul_f32 v[28:29], v[24:25], v[28:29]
  v_pk_mul_f32 v[30:31], v[26:27], v[30:31]
  v_cvt_pk_bf16_f32 v24, v28, v28
  v_cvt_pk_bf16_f32 v25, v29, v29
  v_cvt_pk_bf16_f32 v26, v30, v30
  v_cvt_pk_bf16_f32 v27, v31, v31
  v_min_u32 v24, -2, v24
  v_min_u32 v25, -2, v25
  v_min_u32 v26, -2, v26
  v_min_u32 v27, -2, v27
  s_mov_b32 exec_lo, 0xf
  s_mov_b32 exec_hi, 0
  global_store_dwordx4 v9, v[24:27], s[16:17] sc0 sc1
  s_mov_b64 exec, 1
  ds_add_u32 v44, v45 offset:4
  s_endpgm
L_svc7b:
  s_getreg_b32 s3, hwreg(HW_REG_XCC_ID, 0, 4)
  v_mov_b32 v44, 0
  v_mov_b32 v45, 1
  ds_write_b32 v44, v44
  ds_write_b32 v44, v44 offset:4
  s_lshl_b32 s22, s21, 6
  v_and_b32 v7, 7, v0
  v_lshlrev_b32 v7, 3, v7
  v_bfe_u32 v8, v0, 4, 1
  v_lshl_or_b32 v7, v8, 2, v7
  v_bfe_u32 v8, v0, 5, 1
  v_lshl_or_b32 v7, v8, 1, v7
  v_add_u32 v7, s22, v7
  s_or_b32 s24, s3, 0x10
  s_lshl_b32 s25, s21, 3
  v_mov_b32 v12, s25
  v_mov_b32 v11, s24
  s_waitcnt vmcnt(0) lgkmcnt(0)
  s_barrier
  s_mov_b64 exec, 1
  global_store_byte v12, v11, s[14:15] sc0 sc1
  s_barrier
  s_mov_b64 exec, -1
  s_mov_b32 s46, 0
  s_mov_b32 s47, 0
  s_mov_b32 s45, 0
L_p2:
  global_load_dwordx4 v[16:19], v5, s[16:17] offset:0 sc1
  global_load_dwordx4 v[20:23], v5, s[16:17] offset:1024 sc1
  global_load_dwordx4 v[24:27], v5, s[16:17] offset:2048 sc1
  global_load_dwordx4 v[28:31], v5, s[16:17] offset:3072 sc1
  s_add_u32 s46, s46, 1
  s_branch L_p2x
L_p2w:
  s_waitcnt vmcnt(2)
  v_max3_u32 v8, v16, v17, v18
  v_max3_u32 v9, v20, v21, v22
  v_max3_u32 v8, v8, v19, v23
  v_pk_add_f32 v[32:33], v[16:17], v[20:21]
  v_pk_add_f32 v[34:35], v[18:19], v[22:23]
  s_waitcnt vmcnt(1)
  v_max3_u32 v9, v9, v24, v25
  v_max3_u32 v8, v8, v26, v27
  v_pk_add_f32 v[32:33], v[32:33], v[24:25]
  v_pk_add_f32 v[34:35], v[34:35], v[26:27]
  s_waitcnt vmcnt(0)
  v_max3_u32 v9, v9, v28, v29
  v_max3_u32 v8, v8, v30, v31
  v_max_u32 v8, v8, v9
  v_cmp_eq_u32 vcc, -1, v8
  v_pk_add_f32 v[32:33], v[32:33], v[28:29]
  v_pk_add_f32 v[34:35], v[34:35], v[30:31]
  s_cbranch_vccz L_p2ok
  s_cmp_eq_u32 s45, 7
  s_cbranch_scc0 L_p2
  s_mov_b32 s44, 0
  global_load_dwordx4 v[16:19], v5, s[16:17] offset:0 sc1
  global_load_dwordx4 v[20:23], v5, s[16:17] offset:1024 sc1
  global_load_dwordx4 v[24:27], v5, s[16:17] offset:2048 sc1
  global_load_dwordx4 v[28:31], v5, s[16:17] offset:3072 sc1
L_p2f:
  global_load_dwordx4 v[64:67], v5, s[16:17] offset:0 sc1
  global_load_dwordx4 v[68:71], v5, s[16:17] offset:1024 sc1
  global_load_dwordx4 v[72:75], v5, s[16:17] offset:2048 sc1
  global_load_dwordx4 v[76:79], v5, s[16:17] offset:3072 sc1
  s_waitcnt vmcnt(6)
  v_max3_u32 v8, v16, v17, v18
  v_max3_u32 v9, v20, v21, v22
  v_max3_u32 v8, v8, v19, v23
  v_pk_add_f32 v[32:33], v[16:17], v[20:21]
  v_pk_add_f32 v[34:35], v[18:19], v[22:23]
  s_waitcnt vmcnt(5)
  v_max3_u32 v9, v9, v24, v25
  v_max3_u32 v8, v8, v26, v27
  v_pk_add_f32 v[32:33], v[32:33], v[24:25]
  v_pk_add_f32 v[34:35], v[34:35], v[26:27]
  s_waitcnt vmcnt(4)
  v_max3_u32 v9, v9, v28, v29
  v_max3_u32 v8, v8, v30, v31
  v_max_u32 v8, v8, v9
  v_cmp_eq_u32 vcc, -1, v8
  v_pk_add_f32 v[32:33], v[32:33], v[28:29]
  v_pk_add_f32 v[34:35], v[34:35], v[30:31]
  s_cbranch_vccz L_p2ok
  global_load_dwordx4 v[16:19], v5, s[16:17] offset:0 sc1
  global_load_dwordx4 v[20:23], v5, s[16:17] offset:1024 sc1
  global_load_dwordx4 v[24:27], v5, s[16:17] offset:2048 sc1
  global_load_dwordx4 v[28:31], v5, s[16:17] offset:3072 sc1
  s_waitcnt vmcnt(6)
  v_max3_u32 v8, v64, v65, v66
  v_max3_u32 v9, v68, v69, v70
  v_max3_u32 v8, v8, v67, v71
  v_pk_add_f32 v[32:33], v[64:65], v[68:69]
  v_pk_add_f32 v[34:35], v[66:67], v[70:71]
  s_waitcnt vmcnt(5)
  v_max3_u32 v9, v9, v72, v73
  v_max3_u32 v8, v8, v74, v75
  v_pk_add_f32 v[32:33], v[32:33], v[72:73]
  v_pk_add_f32 v[34:35], v[34:35], v[74:75]
  s_waitcnt vmcnt(4)
  v_max3_u32 v9, v9, v76, v77
  v_max3_u32 v8, v8, v78, v79
  v_max_u32 v8, v8, v9
  v_cmp_eq_u32 vcc, -1, v8
  v_pk_add_f32 v[32:33], v[32:33], v[76:77]
  v_pk_add_f32 v[34:35], v[34:35], v[78:79]
  s_cbranch_vccz L_p2ok
  s_add_u32 s44, s44, 1
  s_cmp_lt_u32 s44, 32
  s_cbranch_scc1 L_p2f
  s_add_u32 s46, s46, 16
  s_waitcnt vmcnt(0)
  s_branch L_p2
L_p2ok:
  s_nop 1
  v_permlane32_swap_b32 v32, v33
  v_permlane32_swap_b32 v34, v35
  v_add_f32 v32, v32, v33
  v_add_f32 v34, v34, v35
  s_nop 1
  v_permlane16_swap_b32 v32, v34
  v_add_f32 v32, v32, v34
  s_nop 1
  v_add_f32_dpp v33, v32, v32 row_ror:8 row_mask:0xf bank_mask:0xf
  v_cvt_pk_bf16_f32 v33, v33, v33
  s_mov_b32 exec_lo, 0x00ff00ff
  s_mov_b32 exec_hi, 0x00ff00ff
  global_store_short v7, v33, s[12:13]
  s_endpgm
L_p2x:
  ds_read_b32 v46, v44 offset:4
  s_waitcnt lgkmcnt(0)
  v_readfirstlane_b32 s45, v46
L_p2y:
  s_cmp_lt_u32 s46, 48
  s_cbranch_scc0 L_p2B
  s_cmp_eq_u32 s45, 7
  s_cbranch_scc1 L_p2w
  s_sleep 6
  s_branch L_p2w
L_hslow:
  v_mov_b32 v111, s73
L_hs1:
  global_load_ubyte v110, v111, s[14:15] sc1
  s_add_u32 s46, s46, 1
  s_waitcnt vmcnt(0)
  v_cmp_eq_u32 vcc, 0, v110
  s_cmp_ge_u32 s46, 8388608
  s_cbranch_scc1 L_h
  s_cbranch_vccz L_h
  s_sleep 8
  s_branch L_hs1
L_flagslow:
  v_and_b32 v111, 3, v0
  v_add_u32 v111, s40, v111
  v_lshlrev_b32 v111, 3, v111
  s_and_b32 s48, s3, 0xff
  s_mov_b32 s49, 0
L_fs1:
  global_load_ubyte v110, v111, s[14:15] sc1
  s_add_u32 s49, s49, 1
  s_waitcnt vmcnt(0) lgkmcnt(0)
  v_cmp_eq_u32 vcc, 0, v110
  s_cmp_ge_u32 s49, 8388608
  s_cbranch_scc1 L_fs2
  s_cbranch_vccz L_fs2
  s_sleep 8
  s_branch L_fs1
L_fs2:
  v_cmp_ne_u32 vcc, s48, v110
  s_mov_b32 s47, 1
  s_cbranch_vccz L_setmode
  s_mov_b32 s47, 2
  s_branch L_setmode
L_slowpub:
  v_lshl_add_u32 v116, v2, 1, v3
  s_lshl_b32 s48, s26, 4
  v_add_u32 v116, s48, v116
  v_mul_u32_u24 v117, 2341, v116
  v_lshrrev_b32 v117, 16, v117
  v_lshlrev_b32 v117, 3, v117
  global_load_ubyte v118, v117, s[14:15] sc1
  s_and_b32 s48, s3, 0xff
  s_mov_b64 s[50:51], exec
  s_waitcnt vmcnt(0)
  v_cmp_eq_u32 vcc, s48, v118
  s_and_b64 exec, s[50:51], vcc
  s_cbranch_execz L_sp1a
  global_store_dwordx4 v104, v[112:115], s[16:17]
L_sp1a:
  s_andn2_b64 exec, s[50:51], vcc
  s_cbranch_execz L_sp3a
  v_add_u32 v116, 2097152, v104
  s_mov_b32 s49, 0
L_sp2a:
  global_load_ubyte v118, v117, s[14:15] offset:1 sc1
  s_add_u32 s49, s49, 1
  s_waitcnt vmcnt(0)
  v_cmp_eq_u32 vcc, 0, v118
  s_cmp_ge_u32 s49, 8388608
  s_cbranch_scc1 L_sp4a
  s_sleep 8
  s_cbranch_vccnz L_sp2a
L_sp4a:
  global_store_dwordx4 v116, v[112:115], s[16:17] sc0 sc1
L_sp3a:
  s_waitcnt vmcnt(0)
  s_branch L_pubdone
L_slowpub2:
  v_add_u32 v117, s40, v108
  v_lshlrev_b32 v117, 3, v117
  global_load_ubyte v118, v117, s[14:15] sc1
  s_and_b32 s48, s3, 0xff
  s_mov_b64 s[50:51], exec
  s_waitcnt vmcnt(0)
  v_cmp_eq_u32 vcc, s48, v118
  s_and_b64 exec, s[50:51], vcc
  s_cbranch_execz L_sp1b
  global_store_dwordx4 v107, v[112:115], s[16:17]
L_sp1b:
  s_andn2_b64 exec, s[50:51], vcc
  s_cbranch_execz L_sp3b
  v_add_u32 v116, 2097152, v107
  s_mov_b32 s49, 0
L_sp2b:
  global_load_ubyte v118, v117, s[14:15] offset:1 sc1
  s_add_u32 s49, s49, 1
  s_waitcnt vmcnt(0)
  v_cmp_eq_u32 vcc, 0, v118
  s_cmp_ge_u32 s49, 8388608
  s_cbranch_scc1 L_sp4b
  s_sleep 8
  s_cbranch_vccnz L_sp2b
L_sp4b:
  global_store_dwordx4 v116, v[112:115], s[16:17] sc0 sc1
L_sp3b:
  s_waitcnt vmcnt(0)
  s_branch L_pub2done
L_p1B:
  ds_read_b32 v33, v44
  s_waitcnt lgkmcnt(0)
  v_cmp_eq_u32 vcc, 0, v33
  s_cbranch_vccnz L_p1w
  v_add_u32 v7, 2097152, v5
  global_load_dwordx4 v[32:35], v7, s[16:17] sc1
  s_waitcnt vmcnt(0)
  v_min_u32 v16, v16, v32
  v_min_u32 v17, v17, v33
  v_min_u32 v18, v18, v34
  v_min_u32 v19, v19, v35
  s_cmp_ge_u32 s46, 8388608
  s_cbranch_scc1 L_p1ok
  s_branch L_p1w
L_p2B:
  s_mov_b32 s45, 0
  v_add_u32 v6, 2097152, v5
  s_cmp_lg_u32 s47, 0
  s_cbranch_scc1 L_p2B2
  s_mov_b32 s47, 1
  v_mov_b32 v48, -1
  v_mov_b32 v49, -1
  v_mov_b32 v50, -1
  v_mov_b32 v51, -1
  s_mul_i32 s22, s21, 7168
  s_add_u32 s22, s22, 2100224
  v_add_u32 v46, s22, v4
  global_store_dwordx4 v46, v[48:51], s[16:17] offset:-3072 sc0 sc1
  global_store_dwordx4 v46, v[48:51], s[16:17] offset:-2048 sc0 sc1
  global_store_dwordx4 v46, v[48:51], s[16:17] offset:-1024 sc0 sc1
  global_store_dwordx4 v46, v[48:51], s[16:17] offset:0 sc0 sc1
  global_store_dwordx4 v46, v[48:51], s[16:17] offset:1024 sc0 sc1
  global_store_dwordx4 v46, v[48:51], s[16:17] offset:2048 sc0 sc1
  global_store_dwordx4 v46, v[48:51], s[16:17] offset:3072 sc0 sc1
  global_store_dwordx4 v6, v[48:51], s[16:17] offset:0 sc0 sc1
  global_store_dwordx4 v6, v[48:51], s[16:17] offset:1024 sc0 sc1
  global_store_dwordx4 v6, v[48:51], s[16:17] offset:2048 sc0 sc1
  global_store_dwordx4 v6, v[48:51], s[16:17] offset:3072 sc0 sc1
  s_waitcnt vmcnt(0)
  s_mov_b64 exec, 1
  ds_write_b32 v44, v45
  global_store_byte v12, v45, s[14:15] offset:1 sc0 sc1
  s_mov_b64 exec, -1
L_p2B2:
  global_load_dwordx4 v[48:51], v6, s[16:17] offset:0 sc1
  global_load_dwordx4 v[52:55], v6, s[16:17] offset:1024 sc1
  global_load_dwordx4 v[56:59], v6, s[16:17] offset:2048 sc1
  global_load_dwordx4 v[60:63], v6, s[16:17] offset:3072 sc1
  s_waitcnt vmcnt(0)
  v_min_u32 v16, v16, v48
  v_min_u32 v17, v17, v49
  v_min_u32 v18, v18, v50
  v_min_u32 v19, v19, v51
  v_min_u32 v20, v20, v52
  v_min_u32 v21, v21, v53
  v_min_u32 v22, v22, v54
  v_min_u32 v23, v23, v55
  v_min_u32 v24, v24, v56
  v_min_u32 v25, v25, v57
  v_min_u32 v26, v26, v58
  v_min_u32 v27, v27, v59
  v_min_u32 v28, v28, v60
  v_min_u32 v29, v29, v61
  v_min_u32 v30, v30, v62
  v_min_u32 v31, v31, v63
  s_cmp_ge_u32 s46, 8388608
  s_cbranch_scc1 L_p2ok
  s_branch L_p2w
.section .rodata,"a"
.p2align 6
.amdhsa_kernel standalone__glu_gated_bilinear__decode_kernel
  .amdhsa_next_free_vgpr 120
  .amdhsa_next_free_sgpr 76
  .amdhsa_accum_offset 120
  .amdhsa_group_segment_fixed_size 0
  .amdhsa_kernarg_size 56
  .amdhsa_user_sgpr_count 2
  .amdhsa_user_sgpr_kernarg_segment_ptr 1
  .amdhsa_system_sgpr_workgroup_id_x 1
  .amdhsa_float_denorm_mode_32 3
.end_amdhsa_kernel
```
